```python
import torch

def _softmax(x, axis=-1):
    return torch.softmax(x, dim=axis)
def _gelu(x):
    return torch.nn.functional.gelu(x, approximate="tanh")
def _silu(x):
    return torch.nn.functional.silu(x)
def _sigmoid(x):
    return torch.sigmoid(x)
def _layernorm(x, axis=-1, eps=1e-5):
    m = x.mean(dim=axis, keepdim=True)
    v = x.var(dim=axis, keepdim=True, unbiased=False)
    return (x - m) / torch.sqrt(v + eps)
def _scatter_add(tgt, idx, src, axis=0):
    return tgt.clone().index_add_(axis, idx, src)
def _segment_sum(src, seg, n):
    out = torch.zeros((n,) + src.shape[1:], dtype=src.dtype)
    return out.index_add_(0, seg, src)
def _pad(x, pw):
    flat = tuple(v for pair in reversed(pw) for v in pair)
    return torch.nn.functional.pad(x, flat)

kernel_name = 'standalone__gqa_block_cached__near_ridge'

def setup_inputs():

    _w = (lambda a: (lambda t: t.to(torch.bfloat16) if t.is_floating_point() else t)(torch.as_tensor(a)))
    B, Sq, D = 16, 64, 512
    Hq, Hkv, Sk, Dh = 32, 32, 64, 128
    assert Hq % Hkv == 0, (Hq, Hkv)
    return {
        "x": _w((lambda *s: torch.randn(*s, dtype=torch.bfloat16) * 0.8)(B, Sq, D)),
        "k_cache": _w((lambda *s: torch.randn(*s, dtype=torch.bfloat16) * 0.8)(B, Hkv, Sk, Dh)),
        "v_cache": _w((lambda *s: torch.randn(*s, dtype=torch.bfloat16) * 0.05)(B, Hkv, Sk, Dh)),
        "wq": _w((lambda *s: torch.randn(*s, dtype=torch.bfloat16) * 0.8)(D, Hq * Dh) * (D ** -0.5)),
        "wo": _w((lambda *s: torch.randn(*s, dtype=torch.bfloat16) * 0.05)(Hq * Dh, D) * ((Hq * Dh) ** -0.5)),
    }

def reference(x, k_cache, v_cache, wq, wo):
    B, Sq, D = x.shape
    Hq, Dh = 32, 128
    Hkv = k_cache.shape[1]
    rep = Hq // Hkv
    q = (lambda x, *d: x.permute(*d))((x @ wq).reshape(B, Sq, Hq, Dh), 0, 2, 1, 3)
    k = (lambda x, n, axis: torch.repeat_interleave(x, n, dim=axis))(k_cache, rep, axis=1)
    v = (lambda x, n, axis: torch.repeat_interleave(x, n, dim=axis))(v_cache, rep, axis=1)
    scores = torch.einsum("bhqd,bhkd->bhqk", q, k) * (Dh ** -0.5)
    p = _softmax(scores, axis=-1)
    o = torch.einsum("bhqk,bhkd->bhqd", p, v)
    return (lambda x, *d: x.permute(*d))(o, 0, 2, 1, 3).reshape(B, Sq, Hq * Dh) @ wo
```

```asm
; @launch grid=(256,1,1) block=(512,1,1) lds=163840
.amdgcn_target "amdgcn-amd-amdhsa--gfx950"
    .text
    .globl standalone__gqa_block_cached__near_ridge_kernel
    .p2align 8
    .type standalone__gqa_block_cached__near_ridge_kernel,@function
standalone__gqa_block_cached__near_ridge_kernel:
    s_cmp_ge_u32 s2, 256
    s_cbranch_scc1 F_DONE
    s_load_dwordx16 s[4:19], s[0:1], 0
    v_and_b32 v1, 63, v0
    v_lshrrev_b32 v2, 6, v0
    s_and_b32 s44, s2, 3
    v_readfirstlane_b32 s42, v2
    s_lshr_b32 s55, s2, 3
    s_and_b32 s43, s55, 7
    s_lshl_b32 s40, s44, 3
    s_add_u32 s40, s40, s43
    s_lshr_b32 s46, s2, 6
    s_and_b32 s41, s2, 4
    s_add_u32 s41, s41, s46
    s_lshl_b32 s48, s46, 1
    s_add_u32 s48, s48, s43
    s_and_b32 s48, s48, 7
    s_lshl_b32 s48, s48, 1
    s_mov_b32 s48, 0
    s_cmp_lt_u32 s42, 4
    s_cbranch_scc1 F_COMPUTE
    s_cmp_eq_u32 s42, 5
    s_cbranch_scc1 F_LX
    s_cmp_gt_u32 s42, 5
    s_cbranch_scc1 F_LKV
    s_lshl_b32 s49, s40, 8
    v_lshrrev_b32 v3, 4, v1
    v_and_b32 v4, 15, v1
    v_lshlrev_b32 v5, 2, v3
    v_xor_b32 v4, v4, v5
    v_lshlrev_b32 v4, 4, v4
    v_lshl_add_u32 v8, v3, 13, v4
    v_add_u32 v9, 31744, v8
    v_add_u32 v10, 63488, v8
    v_add_u32 v11, 95232, v8
    v_add_u32 v12, 131072, v8
    v_add_u32 v13, 162816, v8
    v_add_u32 v14, 194560, v8
    v_add_u32 v15, 226304, v8
    s_mov_b32 s51, 0
    s_mov_b32 s58, 0
    s_waitcnt lgkmcnt(0)
    s_mov_b32 s20, s10
    s_mov_b32 s21, s11
    s_mov_b32 s22, 4194304
    s_mov_b32 s23, 0x00020000
LW_L:
    s_cmp_lt_u32 s58, 3
    s_cbranch_scc1 LW_I
    s_waitcnt vmcnt(16)
    s_barrier
LW_I:
    s_add_u32 s46, s48, s58
    s_and_b32 s46, s46, 15
    s_lshl_b32 s46, s46, 18
    s_add_u32 s46, s46, s49
    s_mov_b32 m0, s51
    s_add_u32 s47, s51, 4096
    buffer_load_dwordx4 v8, s[20:23], s46 offen offset:0  lds
    buffer_load_dwordx4 v9, s[20:23], s46 offen offset:1024  lds
    buffer_load_dwordx4 v10, s[20:23], s46 offen offset:2048  lds
    buffer_load_dwordx4 v11, s[20:23], s46 offen offset:3072  lds
    s_mov_b32 m0, s47
    s_nop 0
    buffer_load_dwordx4 v12, s[20:23], s46 offen offset:0  lds
    buffer_load_dwordx4 v13, s[20:23], s46 offen offset:1024  lds
    buffer_load_dwordx4 v14, s[20:23], s46 offen offset:2048  lds
    buffer_load_dwordx4 v15, s[20:23], s46 offen offset:3072  lds
    s_add_u32 s51, s51, 8192
    s_cmp_eq_u32 s51, 49152
    s_cselect_b32 s51, 0, s51
    s_add_u32 s58, s58, 1
    s_cmp_lt_u32 s58, 16
    s_cbranch_scc1 LW_L
    s_waitcnt vmcnt(16)
    s_barrier
    s_waitcnt vmcnt(8)
    s_barrier
    s_waitcnt vmcnt(0)
    s_barrier
    v_lshrrev_b32 v3, 3, v1
    v_and_b32 v4, 7, v1
    v_bfe_u32 v5, v1, 4, 1
    v_lshlrev_b32 v5, 2, v5
    v_xor_b32 v4, v4, v5
    v_lshlrev_b32 v4, 4, v4
    v_lshl_add_u32 v24, v3, 10, v4
    v_add_u32 v25, 7168, v24
    v_add_u32 v26, 14336, v24
    v_add_u32 v27, 21504, v24
    v_add_u32 v28, 32768, v24
    v_add_u32 v29, 39936, v24
    v_add_u32 v30, 47104, v24
    v_add_u32 v31, 54272, v24
    s_mov_b32 s24, s12
    s_mov_b32 s25, s13
    s_mov_b32 s26, 4194304
    s_mov_b32 s27, 0x00020000
    s_lshl_b32 s49, s44, 20
    s_lshl_b32 s46, s43, 7
    s_add_u32 s49, s49, s46
    s_mov_b32 s51, 0
    s_mov_b32 s58, 0
    s_barrier
    s_barrier
WO_LA:
    s_add_u32 s46, s43, s58
    s_and_b32 s46, s46, 7
    s_lshl_b32 s46, s46, 17
    s_add_u32 s46, s46, s49
    s_waitcnt vmcnt(16)
    s_mov_b32 m0, s51
    s_add_u32 s47, s51, 4096
    buffer_load_dwordx4 v24, s[24:27], s46 offen offset:0  lds
    buffer_load_dwordx4 v25, s[24:27], s46 offen offset:1024  lds
    buffer_load_dwordx4 v26, s[24:27], s46 offen offset:2048  lds
    buffer_load_dwordx4 v27, s[24:27], s46 offen offset:3072  lds
    s_mov_b32 m0, s47
    s_nop 0
    buffer_load_dwordx4 v28, s[24:27], s46 offen offset:0  lds
    buffer_load_dwordx4 v29, s[24:27], s46 offen offset:1024  lds
    buffer_load_dwordx4 v30, s[24:27], s46 offen offset:2048  lds
    buffer_load_dwordx4 v31, s[24:27], s46 offen offset:3072  lds
    s_add_u32 s51, s51, 16384
    s_add_u32 s58, s58, 1
    s_cmp_lg_u32 s58, 6
    s_cbranch_scc1 WO_NA
    s_barrier
WO_NA:
    s_cmp_lt_u32 s58, 8
    s_cbranch_scc1 WO_LA
    s_waitcnt vmcnt(0)
    s_barrier
    s_endpgm
F_LX:
    v_lshrrev_b32 v3, 3, v1
    v_and_b32 v4, 7, v1
    v_lshrrev_b32 v5, 4, v1
    v_xor_b32 v5, v5, v4
    v_lshlrev_b32 v5, 4, v5
    v_lshl_add_u32 v8, v3, 10, v5
    v_xor_b32 v9, 64, v8
    v_add_u32 v9, 7168, v9
    v_add_u32 v10, 14336, v8
    v_add_u32 v11, 14336, v9
    v_add_u32 v12, 32768, v8
    v_add_u32 v13, 32768, v9
    v_add_u32 v14, 47104, v8
    v_add_u32 v15, 47104, v9
    s_lshl_b32 s49, s41, 17
    s_mov_b32 s51, 49152
    s_mov_b32 s58, 0
    s_waitcnt lgkmcnt(0)
    s_mov_b32 s20, s4
    s_mov_b32 s21, s5
    s_mov_b32 s22, 1048576
    s_mov_b32 s23, 0x00020000
LX_L:
    s_cmp_lt_u32 s58, 3
    s_cbranch_scc1 LX_I
    s_waitcnt vmcnt(8)
    s_barrier
LX_I:
    s_add_u32 s46, s48, s58
    s_and_b32 s47, s46, 1
    s_lshl_b32 s47, s47, 16
    s_and_b32 s46, s46, 14
    s_lshl_b32 s46, s46, 6
    s_add_u32 s46, s46, s47
    s_add_u32 s46, s46, s49
    s_mov_b32 m0, s51
    s_add_u32 s47, s51, 4096
    buffer_load_dwordx4 v8, s[20:23], s46 offen offset:0  lds
    buffer_load_dwordx4 v9, s[20:23], s46 offen offset:1024  lds
    buffer_load_dwordx4 v10, s[20:23], s46 offen offset:2048  lds
    buffer_load_dwordx4 v11, s[20:23], s46 offen offset:3072  lds
    s_mov_b32 m0, s47
    s_nop 0
    buffer_load_dwordx4 v12, s[20:23], s46 offen offset:0  lds
    buffer_load_dwordx4 v13, s[20:23], s46 offen offset:1024  lds
    buffer_load_dwordx4 v14, s[20:23], s46 offen offset:2048  lds
    buffer_load_dwordx4 v15, s[20:23], s46 offen offset:3072  lds
    s_add_u32 s51, s51, 8192
    s_cmp_eq_u32 s51, 98304
    s_cselect_b32 s51, 49152, s51
    s_add_u32 s58, s58, 1
    s_cmp_lt_u32 s58, 16
    s_cbranch_scc1 LX_L
    s_waitcnt vmcnt(16)
    s_barrier
    s_waitcnt vmcnt(0)
    s_barrier
    s_waitcnt vmcnt(0)
    s_barrier
    v_lshrrev_b32 v3, 3, v1
    v_and_b32 v4, 7, v1
    v_bfe_u32 v5, v1, 4, 1
    v_lshlrev_b32 v5, 2, v5
    v_xor_b32 v4, v4, v5
    v_lshlrev_b32 v4, 4, v4
    v_lshl_add_u32 v24, v3, 10, v4
    v_add_u32 v25, 7168, v24
    v_add_u32 v26, 14336, v24
    v_add_u32 v27, 21504, v24
    v_add_u32 v28, 32768, v24
    v_add_u32 v29, 39936, v24
    v_add_u32 v30, 47104, v24
    v_add_u32 v31, 54272, v24
    s_mov_b32 s24, s12
    s_mov_b32 s25, s13
    s_mov_b32 s26, 4194304
    s_mov_b32 s27, 0x00020000
    s_lshl_b32 s49, s44, 20
    s_lshl_b32 s46, s43, 7
    s_add_u32 s49, s49, s46
    s_add_u32 s49, s49, 65536
    s_mov_b32 s51, 8192
    s_mov_b32 s58, 0
    s_barrier
    s_barrier
WO_LB:
    s_add_u32 s46, s43, s58
    s_and_b32 s46, s46, 7
    s_lshl_b32 s46, s46, 17
    s_add_u32 s46, s46, s49
    s_waitcnt vmcnt(16)
    s_mov_b32 m0, s51
    s_add_u32 s47, s51, 4096
    buffer_load_dwordx4 v24, s[24:27], s46 offen offset:0  lds
    buffer_load_dwordx4 v25, s[24:27], s46 offen offset:1024  lds
    buffer_load_dwordx4 v26, s[24:27], s46 offen offset:2048  lds
    buffer_load_dwordx4 v27, s[24:27], s46 offen offset:3072  lds
    s_mov_b32 m0, s47
    s_nop 0
    buffer_load_dwordx4 v28, s[24:27], s46 offen offset:0  lds
    buffer_load_dwordx4 v29, s[24:27], s46 offen offset:1024  lds
    buffer_load_dwordx4 v30, s[24:27], s46 offen offset:2048  lds
    buffer_load_dwordx4 v31, s[24:27], s46 offen offset:3072  lds
    s_add_u32 s51, s51, 16384
    s_add_u32 s58, s58, 1
    s_cmp_lg_u32 s58, 6
    s_cbranch_scc1 WO_NB
    s_barrier
WO_NB:
    s_cmp_lt_u32 s58, 8
    s_cbranch_scc1 WO_LB
    s_waitcnt vmcnt(0)
    s_barrier
    s_endpgm
F_LKV:
    v_lshrrev_b32 v3, 4, v1
    v_and_b32 v4, 15, v1
    v_lshlrev_b32 v2, 8, v3
    s_lshl_b32 s49, s41, 6
    s_add_u32 s49, s49, s40
    s_lshl_b32 s49, s49, 14
    v_lshlrev_b32 v18, 7, v1
    s_mov_b32 s58, 0
    s_mov_b32 s50, 0
    s_cmp_eq_u32 s42, 7
    s_cbranch_scc1 F_LV
    v_add_u32 v5, 0, v3
    v_xor_b32 v5, v5, v4
    v_lshl_add_u32 v8, v5, 4, v2
    v_add_u32 v5, 4, v3
    v_xor_b32 v5, v5, v4
    v_lshl_add_u32 v9, v5, 4, v2
    v_add_u32 v5, 8, v3
    v_xor_b32 v5, v5, v4
    v_lshl_add_u32 v10, v5, 4, v2
    v_add_u32 v5, 12, v3
    v_xor_b32 v5, v5, v4
    v_lshl_add_u32 v11, v5, 4, v2
    s_waitcnt lgkmcnt(0)
    s_mov_b32 s20, s6
    s_mov_b32 s21, s7
    s_mov_b32 s22, 8388608
    s_mov_b32 s23, 0x00020000
    s_lshr_b32 s56, s55, 2
    s_add_u32 s56, s56, 4
    s_and_b32 s56, s56, 7
    s_mul_i32 s56, s56, 2
    s_add_u32 s56, s56, 0
    s_mov_b32 s24, s4
    s_mov_b32 s25, s5
    s_mov_b32 s26, 1048576
    s_mov_b32 s27, 0x00020000
    s_mov_b32 s28, s10
    s_mov_b32 s29, s11
    s_mov_b32 s30, 4194304
    s_mov_b32 s31, 0x00020000
    v_lshlrev_b32 v16, 10, v1
    v_lshlrev_b32 v17, 13, v3
    v_lshl_add_u32 v17, v4, 7, v17
    s_lshr_b32 s36, s55, 2
    s_and_b32 s37, s55, 3
    s_max_u32 s57, s36, 4
    s_sub_u32 s57, s57, 4
    s_lshl_b32 s57, s57, 1
    s_cmp_lt_u32 s36, 2
    s_cselect_b32 s57, 99, s57
    s_and_b32 s38, s2, 4
    s_add_u32 s38, s38, s37
    s_lshl_b32 s38, s38, 17
    s_lshl_b32 s46, s36, 7
    s_add_u32 s38, s38, s46
    s_lshl_b32 s39, s55, 17
    s_lshl_b32 s46, s44, 11
    s_add_u32 s39, s39, s46
LK_L:
    s_cmp_lg_u32 s50, s57
    s_cbranch_scc1 LK_E
    buffer_load_dword v20, v16, s[24:27], s38 offen
    s_add_u32 s38, s38, 65536
    buffer_load_dword v20, v16, s[24:27], s38 offen
    buffer_load_dword v21, v17, s[28:31], s39 offen
    s_add_u32 s39, s39, 32768
    buffer_load_dword v21, v17, s[28:31], s39 offen
    s_add_u32 s39, s39, 32768
    buffer_load_dword v21, v17, s[28:31], s39 offen
    s_add_u32 s39, s39, 32768
    buffer_load_dword v21, v17, s[28:31], s39 offen
    s_add_u32 s39, s39, 32768
LK_E:
    s_cmp_lg_u32 s50, s56
    s_cbranch_scc1 LK_S
LK_G:
    s_lshl_b32 s46, s58, 12
    s_add_u32 m0, s46, 98304
    s_and_b32 s46, s46, 0x3000
    s_lshr_b32 s47, s58, 2
    s_lshl_b32 s47, s47, 19
    s_add_u32 s46, s46, s47
    s_add_u32 s46, s46, s49
    buffer_load_dwordx4 v8, s[20:23], s46 offen offset:0  lds
    buffer_load_dwordx4 v9, s[20:23], s46 offen offset:1024  lds
    buffer_load_dwordx4 v10, s[20:23], s46 offen offset:2048  lds
    buffer_load_dwordx4 v11, s[20:23], s46 offen offset:3072  lds
    s_add_u32 s58, s58, 1
    s_cmp_lt_u32 s58, 8
    s_cbranch_scc1 LK_G
LK_S:
    s_barrier
    s_add_u32 s50, s50, 1
    s_cmp_lt_u32 s50, 16
    s_cbranch_scc1 LK_L
    s_waitcnt vmcnt(0)
    s_barrier
    s_endpgm
F_LV:
    v_lshlrev_b32 v5, 2, v3
    v_xor_b32 v5, v5, v4
    v_lshl_add_u32 v8, v5, 4, v2
    s_memrealtime s[52:53]
    s_waitcnt lgkmcnt(0)
    s_mov_b32 s20, s8
    s_mov_b32 s21, s9
    s_mov_b32 s22, 8388608
    s_mov_b32 s23, 0x00020000
    s_mov_b32 s32, s12
    s_mov_b32 s33, s13
    s_mov_b32 s34, 4194304
    s_mov_b32 s35, 0x00020000
    s_cmp_lg_u32 s2, 0
    s_cbranch_scc1 F_NOTOK
    s_mov_b32 s24, s16
    s_mov_b32 s25, s17
    s_mov_b32 s26, 256
    s_mov_b32 s27, 0x00020000
    s_or_b32 s52, s52, 1
    v_mov_b32 v10, s52
    v_mov_b32 v11, s53
    v_mov_b32 v12, 0
    buffer_store_dwordx2 v[10:11], v12, s[24:27], 0 offen sc0 sc1
F_NOTOK:
    s_lshr_b32 s56, s55, 2
    s_add_u32 s56, s56, 4
    s_and_b32 s56, s56, 7
    s_mul_i32 s56, s56, 2
    s_add_u32 s56, s56, 0
LV_L:
    s_cmp_lg_u32 s50, s56
    s_cbranch_scc1 LV_S
LV_G:
    s_lshl_b32 s46, s58, 12
    s_add_u32 m0, s46, 131072
    s_and_b32 s46, s46, 0x3000
    s_lshr_b32 s47, s58, 2
    s_lshl_b32 s47, s47, 19
    s_add_u32 s46, s46, s47
    s_add_u32 s46, s46, s49
    buffer_load_dwordx4 v8, s[20:23], s46 offen offset:0  lds
    buffer_load_dwordx4 v8, s[20:23], s46 offen offset:1024  lds
    buffer_load_dwordx4 v8, s[20:23], s46 offen offset:2048  lds
    buffer_load_dwordx4 v8, s[20:23], s46 offen offset:3072  lds
    s_add_u32 s58, s58, 1
    s_cmp_lt_u32 s58, 8
    s_cbranch_scc1 LV_G
LV_S:
    s_barrier
    s_add_u32 s50, s50, 1
    s_cmp_lt_u32 s50, 16
    s_cbranch_scc1 LV_L
    s_lshl_b32 s46, s44, 20
    s_lshl_b32 s47, s55, 15
    s_add_u32 s46, s46, s47
    buffer_load_dword v23, v18, s[32:35], s46 offen
    s_add_u32 s46, s46, 8192
    buffer_load_dword v23, v18, s[32:35], s46 offen
    s_add_u32 s46, s46, 8192
    buffer_load_dword v23, v18, s[32:35], s46 offen
    s_add_u32 s46, s46, 8192
    buffer_load_dword v23, v18, s[32:35], s46 offen
    s_barrier
    s_waitcnt vmcnt(4)
    s_barrier
    s_endpgm
F_COMPUTE:
    v_and_b32 v3, 31, v1
    v_bfe_u32 v4, v3, 1, 3
    v_lshrrev_b32 v5, 5, v1
    v_xor_b32 v4, v4, v5
    v_lshlrev_b32 v4, 4, v4
    v_lshl_add_u32 v3, v2, 5, v3
    v_lshl_add_u32 v3, v3, 7, v4
    v_add_u32 v3, 49152, v3
    v_xor_b32 v8, 0, v3
    v_xor_b32 v9, 32, v3
    v_xor_b32 v10, 64, v3
    v_xor_b32 v11, 96, v3
    v_bfe_u32 v3, v1, 2, 2
    v_bfe_u32 v4, v1, 4, 1
    v_lshlrev_b32 v4, 2, v4
    v_and_b32 v5, 1, v1
    v_lshl_or_b32 v4, v5, 1, v4
    v_bfe_u32 v5, v1, 1, 1
    v_or_b32 v4, v4, v5
    v_lshlrev_b32 v4, 3, v4
    v_lshrrev_b32 v5, 5, v1
    v_lshl_add_u32 v28, v3, 7, v4
    v_lshl_add_u32 v28, v5, 10, v28
    v_bfe_u32 v29, v1, 3, 1
    v_lshl_add_u32 v28, v29, 6, v28
    v_xor_b32 v29, 64, v28
    v_lshl_add_u32 v4, v3, 8, v4
    v_lshl_add_u32 v4, v3, 6, v4
    v_xor_b32 v24, 0, v4
    v_lshl_add_u32 v12, v5, 11, v24
    v_xor_b32 v25, 64, v4
    v_lshl_add_u32 v13, v5, 11, v25
    v_xor_b32 v26, 128, v4
    v_lshl_add_u32 v14, v5, 11, v26
    v_xor_b32 v27, 192, v4
    v_lshl_add_u32 v15, v5, 11, v27
    v_lshrrev_b32 v2, 7, v0
    v_and_b32 v3, 31, v1
    v_and_b32 v4, 15, v1
    v_xor_b32 v4, v4, v5
    v_lshlrev_b32 v4, 4, v4
    v_lshl_add_u32 v4, v3, 8, v4
    v_lshl_add_u32 v4, v2, 14, v4
    v_add_u32 v4, 98304, v4
    v_xor_b32 v16, 0, v4
    v_xor_b32 v17, 32, v4
    v_xor_b32 v18, 64, v4
    v_xor_b32 v19, 96, v4
    v_xor_b32 v20, 128, v4
    v_xor_b32 v21, 160, v4
    v_xor_b32 v22, 192, v4
    v_xor_b32 v23, 224, v4
    v_lshlrev_b32 v2, 14, v2
    v_lshl_add_u32 v2, v5, 10, v2
    v_add_u32 v2, 131072, v2
    v_add_u32 v24, v24, v2
    v_add_u32 v25, v25, v2
    v_add_u32 v26, v26, v2
    v_add_u32 v27, v27, v2
    v_lshlrev_b32 v6, 4, v1
    v_lshrrev_b32 v2, 6, v0
    v_lshl_add_u32 v2, v2, 5, v3
    v_lshlrev_b32 v2, 10, v2
    v_lshl_add_u32 v7, v5, 4, v2
    v_and_b32 v2, 7, v1
    s_andn2_b32 s46, s2, 0x38
    s_lshl_b32 s46, s46, 2
    s_add_u32 s46, s46, s42
    s_lshl_b32 s56, s46, 13
    s_lshl_b32 s46, s46, 6
    s_add_u32 s46, s46, 16777216
    v_lshlrev_b32 v2, 11, v2
    v_add_u32 v222, s46, v2
    v_add_u32 v226, 524288, v222
    v_and_b32 v2, 3, v1
    s_andn2_b32 s46, s2, 3
    s_lshl_b32 s46, s46, 2
    s_add_u32 s46, s46, s42
    s_lshl_b32 s46, s46, 6
    s_add_u32 s46, s46, 17825792
    v_lshlrev_b32 v2, 8, v2
    v_add_u32 v223, s46, v2
    v_mov_b32 v30, 0
    s_lshl_b32 s46, s2, 2
    s_add_u32 s46, s46, s42
    s_lshl_b32 s54, s46, 6
    s_lshl_b32 s57, s46, 13
    s_waitcnt lgkmcnt(0)
    s_mov_b32 s20, s18
    s_mov_b32 s21, s19
    s_mov_b32 s22, 20971520
    s_mov_b32 s23, 0x00020000
    s_mov_b32 s24, s16
    s_mov_b32 s25, s17
    s_mov_b32 s26, 256
    s_mov_b32 s27, 0x00020000
    s_mov_b32 s28, s14
    s_mov_b32 s29, s15
    s_mov_b32 s30, 1048576
    s_mov_b32 s31, 0x00020000
    s_mov_b32 s45, 0
    s_mov_b32 s39, 0
    v_mov_b32 v72, 0
    v_mov_b32 v73, 0
    v_mov_b32 v74, 0
    v_mov_b32 v75, 0
    v_mov_b32 v76, 0
    v_mov_b32 v77, 0
    v_mov_b32 v78, 0
    v_mov_b32 v79, 0
    v_mov_b32 v80, 0
    v_mov_b32 v81, 0
    v_mov_b32 v82, 0
    v_mov_b32 v83, 0
    v_mov_b32 v84, 0
    v_mov_b32 v85, 0
    v_mov_b32 v86, 0
    v_mov_b32 v87, 0
    v_mov_b32 v88, 0
    v_mov_b32 v89, 0
    v_mov_b32 v90, 0
    v_mov_b32 v91, 0
    v_mov_b32 v92, 0
    v_mov_b32 v93, 0
    v_mov_b32 v94, 0
    v_mov_b32 v95, 0
    v_mov_b32 v96, 0
    v_mov_b32 v97, 0
    v_mov_b32 v98, 0
    v_mov_b32 v99, 0
    v_mov_b32 v100, 0
    v_mov_b32 v101, 0
    v_mov_b32 v102, 0
    v_mov_b32 v103, 0
    v_mov_b32 v104, 0
    v_mov_b32 v105, 0
    v_mov_b32 v106, 0
    v_mov_b32 v107, 0
    v_mov_b32 v108, 0
    v_mov_b32 v109, 0
    v_mov_b32 v110, 0
    v_mov_b32 v111, 0
    v_mov_b32 v112, 0
    v_mov_b32 v113, 0
    v_mov_b32 v114, 0
    v_mov_b32 v115, 0
    v_mov_b32 v116, 0
    v_mov_b32 v117, 0
    v_mov_b32 v118, 0
    v_mov_b32 v119, 0
    v_mov_b32 v120, 0
    v_mov_b32 v121, 0
    v_mov_b32 v122, 0
    v_mov_b32 v123, 0
    v_mov_b32 v124, 0
    v_mov_b32 v125, 0
    v_mov_b32 v126, 0
    v_mov_b32 v127, 0
    v_mov_b32 v128, 0
    v_mov_b32 v129, 0
    v_mov_b32 v130, 0
    v_mov_b32 v131, 0
    v_mov_b32 v132, 0
    v_mov_b32 v133, 0
    v_mov_b32 v134, 0
    v_mov_b32 v135, 0
    s_barrier
    ds_read_b128 v[32:35], v8
    ds_read_b64_tr_b16 v[40:41], v12 offset:0
    ds_read_b64_tr_b16 v[42:43], v12 offset:1024
    ds_read_b64_tr_b16 v[44:45], v13 offset:0
    ds_read_b64_tr_b16 v[46:47], v13 offset:1024
    ds_read_b64_tr_b16 v[48:49], v14 offset:0
    ds_read_b64_tr_b16 v[50:51], v14 offset:1024
    ds_read_b64_tr_b16 v[52:53], v15 offset:0
    ds_read_b64_tr_b16 v[54:55], v15 offset:1024
    s_mov_b32 s50, 0
    s_mov_b32 s51, 0
    s_mov_b32 s60, -32768
    s_mov_b32 s61, 16384
QP_L:
    s_add_u32 s51, s51, 16384
    s_cmp_eq_u32 s51, 49152
    s_cselect_b32 s59, s60, s61
    s_cselect_b32 s51, 0, s51
    s_waitcnt lgkmcnt(6)
    v_mfma_f32_32x32x16_bf16 v[72:87], v[40:43], v[32:35], v[72:87]
    ds_read_b128 v[36:39], v9
    ds_read_b64_tr_b16 v[56:57], v12 offset:4096
    ds_read_b64_tr_b16 v[58:59], v12 offset:5120
    s_waitcnt lgkmcnt(7)
    v_mfma_f32_32x32x16_bf16 v[88:103], v[44:47], v[32:35], v[88:103]
    ds_read_b64_tr_b16 v[60:61], v13 offset:4096
    ds_read_b64_tr_b16 v[62:63], v13 offset:5120
    v_add_u32 v8, s59, v8
    s_waitcnt lgkmcnt(7)
    v_mfma_f32_32x32x16_bf16 v[104:119], v[48:51], v[32:35], v[104:119]
    ds_read_b64_tr_b16 v[64:65], v14 offset:4096
    ds_read_b64_tr_b16 v[66:67], v14 offset:5120
    s_waitcnt lgkmcnt(7)
    v_mfma_f32_32x32x16_bf16 v[120:135], v[52:55], v[32:35], v[120:135]
    ds_read_b64_tr_b16 v[68:69], v15 offset:4096
    ds_read_b64_tr_b16 v[70:71], v15 offset:5120
    s_barrier
    s_waitcnt lgkmcnt(6)
    v_mfma_f32_32x32x16_bf16 v[72:87], v[56:59], v[36:39], v[72:87]
    ds_read_b128 v[32:35], v10
    ds_read_b64_tr_b16 v[40:41], v12 offset:8192
    ds_read_b64_tr_b16 v[42:43], v12 offset:9216
    s_waitcnt lgkmcnt(7)
    v_mfma_f32_32x32x16_bf16 v[88:103], v[60:63], v[36:39], v[88:103]
    ds_read_b64_tr_b16 v[44:45], v13 offset:8192
    ds_read_b64_tr_b16 v[46:47], v13 offset:9216
    s_waitcnt lgkmcnt(7)
    v_mfma_f32_32x32x16_bf16 v[104:119], v[64:67], v[36:39], v[104:119]
    ds_read_b64_tr_b16 v[48:49], v14 offset:8192
    ds_read_b64_tr_b16 v[50:51], v14 offset:9216
    s_waitcnt lgkmcnt(7)
    v_mfma_f32_32x32x16_bf16 v[120:135], v[68:71], v[36:39], v[120:135]
    ds_read_b64_tr_b16 v[52:53], v15 offset:8192
    ds_read_b64_tr_b16 v[54:55], v15 offset:9216
    s_waitcnt lgkmcnt(6)
    v_mfma_f32_32x32x16_bf16 v[72:87], v[40:43], v[32:35], v[72:87]
    ds_read_b128 v[36:39], v11
    ds_read_b64_tr_b16 v[56:57], v12 offset:12288
    ds_read_b64_tr_b16 v[58:59], v12 offset:13312
    v_add_u32 v12, s59, v12
    s_waitcnt lgkmcnt(7)
    v_mfma_f32_32x32x16_bf16 v[88:103], v[44:47], v[32:35], v[88:103]
    ds_read_b64_tr_b16 v[60:61], v13 offset:12288
    ds_read_b64_tr_b16 v[62:63], v13 offset:13312
    v_add_u32 v13, s59, v13
    s_waitcnt lgkmcnt(7)
    v_mfma_f32_32x32x16_bf16 v[104:119], v[48:51], v[32:35], v[104:119]
    ds_read_b64_tr_b16 v[64:65], v14 offset:12288
    ds_read_b64_tr_b16 v[66:67], v14 offset:13312
    v_add_u32 v14, s59, v14
    s_waitcnt lgkmcnt(7)
    v_mfma_f32_32x32x16_bf16 v[120:135], v[52:55], v[32:35], v[120:135]
    ds_read_b64_tr_b16 v[68:69], v15 offset:12288
    ds_read_b64_tr_b16 v[70:71], v15 offset:13312
    v_add_u32 v15, s59, v15
    s_barrier
    s_waitcnt lgkmcnt(6)
    v_mfma_f32_32x32x16_bf16 v[72:87], v[56:59], v[36:39], v[72:87]
    ds_read_b128 v[32:35], v8
    ds_read_b64_tr_b16 v[40:41], v12 offset:0
    ds_read_b64_tr_b16 v[42:43], v12 offset:1024
    s_waitcnt lgkmcnt(7)
    v_mfma_f32_32x32x16_bf16 v[88:103], v[60:63], v[36:39], v[88:103]
    ds_read_b64_tr_b16 v[44:45], v13 offset:0
    ds_read_b64_tr_b16 v[46:47], v13 offset:1024
    v_add_u32 v9, s59, v9
    s_waitcnt lgkmcnt(7)
    v_mfma_f32_32x32x16_bf16 v[104:119], v[64:67], v[36:39], v[104:119]
    ds_read_b64_tr_b16 v[48:49], v14 offset:0
    ds_read_b64_tr_b16 v[50:51], v14 offset:1024
    v_add_u32 v10, s59, v10
    s_waitcnt lgkmcnt(7)
    v_mfma_f32_32x32x16_bf16 v[120:135], v[68:71], v[36:39], v[120:135]
    ds_read_b64_tr_b16 v[52:53], v15 offset:0
    ds_read_b64_tr_b16 v[54:55], v15 offset:1024
    v_add_u32 v11, s59, v11
    s_add_u32 s50, s50, 1
    s_cmp_lt_u32 s50, 8
    s_cbranch_scc1 QP_L
    s_waitcnt lgkmcnt(0)
    s_barrier
F_ATT:
    ds_read_b128 v[200:203], v16 offset:0
    ds_read_b128 v[204:207], v17 offset:0
    ds_read_b128 v[208:211], v18 offset:0
    ds_read_b128 v[212:215], v19 offset:0
    s_mov_b32 s46, 0x3e0293ee
    s_mov_b32 s47, 0x3e0293ee
    s_nop 7
    v_cvt_pk_bf16_f32 v168, v72, v73
    v_cvt_pk_bf16_f32 v169, v74, v75
    v_cvt_pk_bf16_f32 v170, v76, v77
    v_cvt_pk_bf16_f32 v171, v78, v79
    v_cvt_pk_bf16_f32 v172, v80, v81
    v_cvt_pk_bf16_f32 v173, v82, v83
    s_waitcnt lgkmcnt(3)
    v_mfma_f32_32x32x16_bf16 v[136:151], v[200:203], v[168:171], 0
    ds_read_b128 v[200:203], v20 offset:0
    v_cvt_pk_bf16_f32 v174, v84, v85
    v_cvt_pk_bf16_f32 v175, v86, v87
    v_cvt_pk_bf16_f32 v176, v88, v89
    v_cvt_pk_bf16_f32 v177, v90, v91
    s_waitcnt lgkmcnt(3)
    v_mfma_f32_32x32x16_bf16 v[136:151], v[204:207], v[172:175], v[136:151]
    ds_read_b128 v[204:207], v21 offset:0
    v_cvt_pk_bf16_f32 v178, v92, v93
    v_cvt_pk_bf16_f32 v179, v94, v95
    v_cvt_pk_bf16_f32 v180, v96, v97
    v_cvt_pk_bf16_f32 v181, v98, v99
    s_waitcnt lgkmcnt(3)
    v_mfma_f32_32x32x16_bf16 v[136:151], v[208:211], v[176:179], v[136:151]
    ds_read_b128 v[208:211], v22 offset:0
    v_cvt_pk_bf16_f32 v182, v100, v101
    v_cvt_pk_bf16_f32 v183, v102, v103
    v_cvt_pk_bf16_f32 v184, v104, v105
    v_cvt_pk_bf16_f32 v185, v106, v107
    s_waitcnt lgkmcnt(3)
    v_mfma_f32_32x32x16_bf16 v[136:151], v[212:215], v[180:183], v[136:151]
    ds_read_b128 v[212:215], v23 offset:0
    v_cvt_pk_bf16_f32 v186, v108, v109
    v_cvt_pk_bf16_f32 v187, v110, v111
    v_cvt_pk_bf16_f32 v188, v112, v113
    v_cvt_pk_bf16_f32 v189, v114, v115
    s_waitcnt lgkmcnt(3)
    v_mfma_f32_32x32x16_bf16 v[136:151], v[200:203], v[184:187], v[136:151]
    ds_read_b128 v[200:203], v16 offset:8192
    v_cvt_pk_bf16_f32 v190, v116, v117
    v_cvt_pk_bf16_f32 v191, v118, v119
    v_cvt_pk_bf16_f32 v192, v120, v121
    v_cvt_pk_bf16_f32 v193, v122, v123
    s_waitcnt lgkmcnt(3)
    v_mfma_f32_32x32x16_bf16 v[136:151], v[204:207], v[188:191], v[136:151]
    ds_read_b128 v[204:207], v17 offset:8192
    v_cvt_pk_bf16_f32 v194, v124, v125
    v_cvt_pk_bf16_f32 v195, v126, v127
    v_cvt_pk_bf16_f32 v196, v128, v129
    v_cvt_pk_bf16_f32 v197, v130, v131
    s_waitcnt lgkmcnt(3)
    v_mfma_f32_32x32x16_bf16 v[136:151], v[208:211], v[192:195], v[136:151]
    ds_read_b128 v[208:211], v18 offset:8192
    v_cvt_pk_bf16_f32 v198, v132, v133
    v_cvt_pk_bf16_f32 v199, v134, v135
    s_nop 1
    s_waitcnt lgkmcnt(3)
    v_mfma_f32_32x32x16_bf16 v[136:151], v[212:215], v[196:199], v[136:151]
    ds_read_b128 v[212:215], v19 offset:8192
    s_waitcnt lgkmcnt(3)
    v_mfma_f32_32x32x16_bf16 v[152:167], v[200:203], v[168:171], 0
    ds_read_b128 v[200:203], v20 offset:8192
    s_waitcnt lgkmcnt(3)
    v_mfma_f32_32x32x16_bf16 v[152:167], v[204:207], v[172:175], v[152:167]
    ds_read_b128 v[204:207], v21 offset:8192
    s_waitcnt lgkmcnt(3)
    v_mfma_f32_32x32x16_bf16 v[152:167], v[208:211], v[176:179], v[152:167]
    ds_read_b128 v[208:211], v22 offset:8192
    s_waitcnt lgkmcnt(3)
    v_mfma_f32_32x32x16_bf16 v[152:167], v[212:215], v[180:183], v[152:167]
    ds_read_b128 v[212:215], v23 offset:8192
    s_waitcnt lgkmcnt(3)
    v_mfma_f32_32x32x16_bf16 v[152:167], v[200:203], v[184:187], v[152:167]
    v_max3_f32 v216, v136, v137, v138
    v_max3_f32 v217, v139, v140, v141
    s_waitcnt lgkmcnt(2)
    v_mfma_f32_32x32x16_bf16 v[152:167], v[204:207], v[188:191], v[152:167]
    v_max3_f32 v216, v216, v142, v143
    v_max3_f32 v217, v217, v144, v145
    s_waitcnt lgkmcnt(1)
    v_mfma_f32_32x32x16_bf16 v[152:167], v[208:211], v[192:195], v[152:167]
    v_max3_f32 v216, v216, v146, v147
    v_max3_f32 v217, v217, v148, v149
    s_waitcnt lgkmcnt(0)
    v_mfma_f32_32x32x16_bf16 v[152:167], v[212:215], v[196:199], v[152:167]
    v_max3_f32 v216, v216, v150, v151
F_SEG1:
    ds_read_b64_tr_b16 v[32:33], v24 offset:0
    ds_read_b64_tr_b16 v[34:35], v24 offset:2048
    ds_read_b64_tr_b16 v[36:37], v25 offset:0
    ds_read_b64_tr_b16 v[38:39], v25 offset:2048
    ds_read_b64_tr_b16 v[40:41], v26 offset:0
    ds_read_b64_tr_b16 v[42:43], v26 offset:2048
    ds_read_b64_tr_b16 v[44:45], v27 offset:0
    ds_read_b64_tr_b16 v[46:47], v27 offset:2048
    s_nop 5
    v_max3_f32 v216, v216, v152, v153
    v_max3_f32 v217, v217, v154, v155
    v_max3_f32 v216, v216, v156, v157
    v_max3_f32 v217, v217, v158, v159
    v_max3_f32 v216, v216, v160, v161
    v_max3_f32 v217, v217, v162, v163
    v_max3_f32 v216, v216, v164, v165
    v_max3_f32 v217, v217, v166, v167
    v_max_f32 v216, v216, v217
    v_mov_b32 v217, v216
    s_nop 1
    v_permlane32_swap_b32 v216, v217
    s_nop 1
    v_max_f32 v216, v216, v217
    v_mul_f32 v216, s46, v216
    v_fma_f32 v136, v136, s46, -v216
    v_fma_f32 v137, v137, s46, -v216
    v_fma_f32 v138, v138, s46, -v216
    v_fma_f32 v139, v139, s46, -v216
    v_fma_f32 v140, v140, s46, -v216
    v_fma_f32 v141, v141, s46, -v216
    v_fma_f32 v142, v142, s46, -v216
    v_fma_f32 v143, v143, s46, -v216
    v_exp_f32 v136, v136
    v_exp_f32 v137, v137
    v_exp_f32 v138, v138
    v_exp_f32 v139, v139
    v_exp_f32 v140, v140
    v_exp_f32 v141, v141
    v_exp_f32 v142, v142
    v_exp_f32 v143, v143
    s_nop 0
    v_cvt_pk_bf16_f32 v168, v136, v137
    v_cvt_pk_bf16_f32 v169, v138, v139
    v_cvt_pk_bf16_f32 v170, v140, v141
    v_cvt_pk_bf16_f32 v171, v142, v143
    s_nop 0
    s_waitcnt lgkmcnt(0)
    v_mfma_f32_32x32x16_bf16 v[72:87], v[32:35], v[168:171], 0
    ds_read_b64_tr_b16 v[48:49], v24 offset:4096
    ds_read_b64_tr_b16 v[50:51], v24 offset:6144
    ds_read_b64_tr_b16 v[52:53], v25 offset:4096
    ds_read_b64_tr_b16 v[54:55], v25 offset:6144
    ds_read_b64_tr_b16 v[56:57], v26 offset:4096
    ds_read_b64_tr_b16 v[58:59], v26 offset:6144
    ds_read_b64_tr_b16 v[60:61], v27 offset:4096
    ds_read_b64_tr_b16 v[62:63], v27 offset:6144
    v_fma_f32 v144, v144, s46, -v216
    v_fma_f32 v145, v145, s46, -v216
    v_fma_f32 v146, v146, s46, -v216
    v_fma_f32 v147, v147, s46, -v216
    v_fma_f32 v148, v148, s46, -v216
    v_fma_f32 v149, v149, s46, -v216
    v_fma_f32 v150, v150, s46, -v216
    v_mfma_f32_32x32x16_bf16 v[88:103], v[36:39], v[168:171], 0
    v_fma_f32 v151, v151, s46, -v216
    v_exp_f32 v144, v144
    v_exp_f32 v145, v145
    v_exp_f32 v146, v146
    v_exp_f32 v147, v147
    v_exp_f32 v148, v148
    v_exp_f32 v149, v149
    v_mfma_f32_32x32x16_bf16 v[104:119], v[40:43], v[168:171], 0
    v_exp_f32 v150, v150
    v_exp_f32 v151, v151
    s_nop 0
    v_cvt_pk_bf16_f32 v172, v144, v145
    v_cvt_pk_bf16_f32 v173, v146, v147
    v_cvt_pk_bf16_f32 v174, v148, v149
    v_cvt_pk_bf16_f32 v175, v150, v151
    v_mfma_f32_32x32x16_bf16 v[120:135], v[44:47], v[168:171], 0
    v_add_f32 v218, v136, v137
    v_add_f32 v219, v138, v139
    v_add_f32 v218, v218, v140
    v_add_f32 v219, v219, v141
    v_add_f32 v218, v218, v142
    v_add_f32 v219, v219, v143
    s_nop 1
    s_waitcnt lgkmcnt(0)
    v_mfma_f32_32x32x16_bf16 v[72:87], v[48:51], v[172:175], v[72:87]
    ds_read_b64_tr_b16 v[32:33], v24 offset:8192
    ds_read_b64_tr_b16 v[34:35], v24 offset:10240
    ds_read_b64_tr_b16 v[36:37], v25 offset:8192
    ds_read_b64_tr_b16 v[38:39], v25 offset:10240
    ds_read_b64_tr_b16 v[40:41], v26 offset:8192
    ds_read_b64_tr_b16 v[42:43], v26 offset:10240
    ds_read_b64_tr_b16 v[44:45], v27 offset:8192
    ds_read_b64_tr_b16 v[46:47], v27 offset:10240
    v_fma_f32 v152, v152, s46, -v216
    v_fma_f32 v153, v153, s46, -v216
    v_fma_f32 v154, v154, s46, -v216
    v_fma_f32 v155, v155, s46, -v216
    v_fma_f32 v156, v156, s46, -v216
    v_fma_f32 v157, v157, s46, -v216
    v_fma_f32 v158, v158, s46, -v216
    v_fma_f32 v159, v159, s46, -v216
    v_mfma_f32_32x32x16_bf16 v[88:103], v[52:55], v[172:175], v[88:103]
    v_exp_f32 v152, v152
    v_exp_f32 v153, v153
    v_exp_f32 v154, v154
    v_exp_f32 v155, v155
    v_exp_f32 v156, v156
    v_exp_f32 v157, v157
    v_exp_f32 v158, v158
    v_exp_f32 v159, v159
    v_mfma_f32_32x32x16_bf16 v[104:119], v[56:59], v[172:175], v[104:119]
    s_nop 0
    v_cvt_pk_bf16_f32 v176, v152, v153
    v_cvt_pk_bf16_f32 v177, v154, v155
    v_cvt_pk_bf16_f32 v178, v156, v157
    v_cvt_pk_bf16_f32 v179, v158, v159
    v_add_f32 v218, v218, v144
    v_add_f32 v219, v219, v145
    v_add_f32 v218, v218, v146
    v_mfma_f32_32x32x16_bf16 v[120:135], v[60:63], v[172:175], v[120:135]
    v_add_f32 v219, v219, v147
    v_add_f32 v218, v218, v148
    v_add_f32 v219, v219, v149
    v_add_f32 v218, v218, v150
    v_add_f32 v219, v219, v151
    s_nop 1
F_SEG2:
    s_waitcnt lgkmcnt(0)
    v_mfma_f32_32x32x16_bf16 v[72:87], v[32:35], v[176:179], v[72:87]
    ds_read_b64_tr_b16 v[48:49], v24 offset:12288
    ds_read_b64_tr_b16 v[50:51], v24 offset:14336
    ds_read_b64_tr_b16 v[52:53], v25 offset:12288
    ds_read_b64_tr_b16 v[54:55], v25 offset:14336
    ds_read_b64_tr_b16 v[56:57], v26 offset:12288
    ds_read_b64_tr_b16 v[58:59], v26 offset:14336
    ds_read_b64_tr_b16 v[60:61], v27 offset:12288
    ds_read_b64_tr_b16 v[62:63], v27 offset:14336
    v_fma_f32 v160, v160, s46, -v216
    v_fma_f32 v161, v161, s46, -v216
    v_fma_f32 v162, v162, s46, -v216
    v_fma_f32 v163, v163, s46, -v216
    v_fma_f32 v164, v164, s46, -v216
    v_fma_f32 v165, v165, s46, -v216
    v_fma_f32 v166, v166, s46, -v216
    v_fma_f32 v167, v167, s46, -v216
    v_mfma_f32_32x32x16_bf16 v[88:103], v[36:39], v[176:179], v[88:103]
    v_exp_f32 v160, v160
    v_exp_f32 v161, v161
    v_exp_f32 v162, v162
    v_exp_f32 v163, v163
    v_exp_f32 v164, v164
    v_exp_f32 v165, v165
    v_exp_f32 v166, v166
    v_exp_f32 v167, v167
    v_mfma_f32_32x32x16_bf16 v[104:119], v[40:43], v[176:179], v[104:119]
    s_nop 0
    v_cvt_pk_bf16_f32 v180, v160, v161
    v_cvt_pk_bf16_f32 v181, v162, v163
    v_cvt_pk_bf16_f32 v182, v164, v165
    v_cvt_pk_bf16_f32 v183, v166, v167
    v_add_f32 v218, v218, v152
    v_add_f32 v219, v219, v153
    v_add_f32 v218, v218, v154
    v_mfma_f32_32x32x16_bf16 v[120:135], v[44:47], v[176:179], v[120:135]
    v_add_f32 v219, v219, v155
    v_add_f32 v218, v218, v156
    v_add_f32 v219, v219, v157
    v_add_f32 v218, v218, v158
    v_add_f32 v219, v219, v159
    s_nop 1
    s_waitcnt lgkmcnt(0)
    v_mfma_f32_32x32x16_bf16 v[72:87], v[48:51], v[180:183], v[72:87]
    v_add_f32 v218, v218, v160
    v_add_f32 v219, v219, v161
    v_add_f32 v218, v218, v162
    v_add_f32 v219, v219, v163
    v_add_f32 v218, v218, v164
    v_mfma_f32_32x32x16_bf16 v[88:103], v[52:55], v[180:183], v[88:103]
    v_add_f32 v219, v219, v165
    v_add_f32 v218, v218, v166
    v_add_f32 v219, v219, v167
    v_add_f32 v218, v218, v219
    v_mov_b32 v219, v218
    v_mfma_f32_32x32x16_bf16 v[104:119], v[56:59], v[180:183], v[104:119]
    s_nop 1
    v_permlane32_swap_b32 v218, v219
    s_nop 1
    v_add_f32 v218, v218, v219
    v_rcp_f32 v228, v218
    v_mfma_f32_32x32x16_bf16 v[120:135], v[60:63], v[180:183], v[120:135]
    s_nop 0
    v_mov_b32 v229, v228
    s_nop 3
    v_mov_b32 v192, 0
    v_mov_b32 v193, 0
    v_mov_b32 v194, 0
    v_mov_b32 v195, 0
    v_mov_b32 v196, 0
    v_mov_b32 v197, 0
    v_mov_b32 v198, 0
    v_mov_b32 v199, 0
    v_pk_mul_f32 v[72:73], v[72:73], v[228:229]
    v_pk_mul_f32 v[74:75], v[74:75], v[228:229]
    v_pk_mul_f32 v[76:77], v[76:77], v[228:229]
    v_pk_mul_f32 v[78:79], v[78:79], v[228:229]
    v_cvt_pk_bf16_f32 v136, v72, v73
    v_cvt_pk_bf16_f32 v137, v74, v75
    v_cvt_pk_bf16_f32 v138, v76, v77
    v_cvt_pk_bf16_f32 v139, v78, v79
    v_pk_mul_f32 v[80:81], v[80:81], v[228:229]
    v_pk_mul_f32 v[82:83], v[82:83], v[228:229]
    v_pk_mul_f32 v[84:85], v[84:85], v[228:229]
    v_pk_mul_f32 v[86:87], v[86:87], v[228:229]
    v_cvt_pk_bf16_f32 v140, v80, v81
    v_cvt_pk_bf16_f32 v141, v82, v83
    v_cvt_pk_bf16_f32 v142, v84, v85
    v_cvt_pk_bf16_f32 v143, v86, v87
    v_pk_mul_f32 v[88:89], v[88:89], v[228:229]
    v_pk_mul_f32 v[90:91], v[90:91], v[228:229]
    v_pk_mul_f32 v[92:93], v[92:93], v[228:229]
    v_pk_mul_f32 v[94:95], v[94:95], v[228:229]
    v_cvt_pk_bf16_f32 v144, v88, v89
    v_cvt_pk_bf16_f32 v145, v90, v91
    v_cvt_pk_bf16_f32 v146, v92, v93
    v_cvt_pk_bf16_f32 v147, v94, v95
    v_pk_mul_f32 v[96:97], v[96:97], v[228:229]
    v_pk_mul_f32 v[98:99], v[98:99], v[228:229]
    v_pk_mul_f32 v[100:101], v[100:101], v[228:229]
    v_pk_mul_f32 v[102:103], v[102:103], v[228:229]
    v_cvt_pk_bf16_f32 v148, v96, v97
    v_cvt_pk_bf16_f32 v149, v98, v99
    v_cvt_pk_bf16_f32 v150, v100, v101
    v_cvt_pk_bf16_f32 v151, v102, v103
    v_pk_mul_f32 v[104:105], v[104:105], v[228:229]
    v_pk_mul_f32 v[106:107], v[106:107], v[228:229]
    v_pk_mul_f32 v[108:109], v[108:109], v[228:229]
    v_pk_mul_f32 v[110:111], v[110:111], v[228:229]
    v_cvt_pk_bf16_f32 v152, v104, v105
    v_cvt_pk_bf16_f32 v153, v106, v107
    v_cvt_pk_bf16_f32 v154, v108, v109
    v_cvt_pk_bf16_f32 v155, v110, v111
    v_pk_mul_f32 v[112:113], v[112:113], v[228:229]
    v_pk_mul_f32 v[114:115], v[114:115], v[228:229]
    v_pk_mul_f32 v[116:117], v[116:117], v[228:229]
    v_pk_mul_f32 v[118:119], v[118:119], v[228:229]
    v_cvt_pk_bf16_f32 v156, v112, v113
    v_cvt_pk_bf16_f32 v157, v114, v115
    v_cvt_pk_bf16_f32 v158, v116, v117
    v_cvt_pk_bf16_f32 v159, v118, v119
    v_pk_mul_f32 v[120:121], v[120:121], v[228:229]
    v_pk_mul_f32 v[122:123], v[122:123], v[228:229]
    v_pk_mul_f32 v[124:125], v[124:125], v[228:229]
    v_pk_mul_f32 v[126:127], v[126:127], v[228:229]
    v_cvt_pk_bf16_f32 v160, v120, v121
    v_cvt_pk_bf16_f32 v161, v122, v123
    v_cvt_pk_bf16_f32 v162, v124, v125
    v_cvt_pk_bf16_f32 v163, v126, v127
    v_pk_mul_f32 v[128:129], v[128:129], v[228:229]
    v_pk_mul_f32 v[130:131], v[130:131], v[228:229]
    v_pk_mul_f32 v[132:133], v[132:133], v[228:229]
    v_pk_mul_f32 v[134:135], v[134:135], v[228:229]
    v_cvt_pk_bf16_f32 v164, v128, v129
    v_cvt_pk_bf16_f32 v165, v130, v131
    v_cvt_pk_bf16_f32 v166, v132, v133
    v_cvt_pk_bf16_f32 v167, v134, v135
    s_add_u32 s47, s57, 4096
    buffer_store_dwordx4 v[136:139], v6, s[20:23], s57 offen offset:0 sc1
    buffer_store_dwordx4 v[140:143], v6, s[20:23], s57 offen offset:1024 sc1
    buffer_store_dwordx4 v[144:147], v6, s[20:23], s57 offen offset:2048 sc1
    buffer_store_dwordx4 v[148:151], v6, s[20:23], s57 offen offset:3072 sc1
    buffer_store_dwordx4 v[152:155], v6, s[20:23], s47 offen offset:0 sc1
    buffer_store_dwordx4 v[156:159], v6, s[20:23], s47 offen offset:1024 sc1
    buffer_store_dwordx4 v[160:163], v6, s[20:23], s47 offen offset:2048 sc1
    buffer_store_dwordx4 v[164:167], v6, s[20:23], s47 offen offset:3072 sc1
    s_mov_b32 s50, 0
    s_barrier
    v_mov_b32 v168, 0
    v_mov_b32 v169, 0
    v_mov_b32 v170, 0
    v_mov_b32 v171, 0
    v_mov_b32 v172, 0
    v_mov_b32 v173, 0
    v_mov_b32 v174, 0
    v_mov_b32 v175, 0
    v_mov_b32 v176, 0
    v_mov_b32 v177, 0
    v_mov_b32 v178, 0
    v_mov_b32 v179, 0
    v_mov_b32 v180, 0
    v_mov_b32 v181, 0
    v_mov_b32 v182, 0
    v_mov_b32 v183, 0
    v_mov_b32 v184, 0
    v_mov_b32 v185, 0
    v_mov_b32 v186, 0
    v_mov_b32 v187, 0
    v_mov_b32 v188, 0
    v_mov_b32 v189, 0
    v_mov_b32 v190, 0
    v_mov_b32 v191, 0
    s_mov_b64 exec, 1
F_TOKL:
    buffer_load_dwordx2 v[220:221], v30, s[24:27], 0 offen sc0 sc1
    s_waitcnt vmcnt(0)
    v_readfirstlane_b32 s52, v220
    v_readfirstlane_b32 s53, v221
    s_add_u32 s50, s50, 1
    s_cmp_gt_u32 s50, 200000
    s_cbranch_scc1 F_TOKX
    s_cmp_eq_u32 s52, 0
    s_cbranch_scc1 F_TOKL
F_TOKX:
    s_add_u32 s46, s54, 16777216
    s_add_u32 s47, s54, 17301504
    s_mov_b64 exec, 1
    buffer_store_dwordx2 v[220:221], v30, s[20:23], s47 offen
    buffer_store_dwordx2 v[220:221], v30, s[20:23], s46 offen sc1
    s_mov_b64 exec, -1
    s_barrier
    s_mov_b32 s50, 0
    s_mov_b64 exec, 255
F_P1:
    s_and_b32 s46, s50, 7
    s_cmp_eq_u32 s46, 7
    s_cbranch_scc1 F_P1_B
    buffer_load_dwordx2 v[224:225], v226, s[20:23], 0 offen sc1
    s_branch F_P1_C
F_P1_B:
    buffer_load_dwordx2 v[224:225], v222, s[20:23], 0 offen sc0 sc1
F_P1_C:
    s_add_u32 s50, s50, 1
    s_waitcnt vmcnt(0)
    v_cmp_ne_u64 vcc, s[52:53], v[224:225]
    s_cmp_gt_u32 s50, 200000
    s_cbranch_scc1 F_P1_X
    s_nop 2
    s_cbranch_vccz F_P1_X
    s_branch F_P1
F_P1_X:
    s_mov_b64 exec, -1
    s_mov_b32 s58, 0
    v_add_u32 v3, 4096, v6
    s_add_u32 s36, s43, s58
    s_add_u32 s36, s36, 1
    s_and_b32 s36, s36, 7
    s_lshl_b32 s36, s36, 18
    s_add_u32 s36, s36, s56
    buffer_load_dwordx4 v[32:35], v6, s[20:23], s36 offen offset:0 sc1
    buffer_load_dwordx4 v[36:39], v6, s[20:23], s36 offen offset:1024 sc1
    buffer_load_dwordx4 v[40:43], v6, s[20:23], s36 offen offset:2048 sc1
    buffer_load_dwordx4 v[44:47], v6, s[20:23], s36 offen offset:3072 sc1
    ds_read_b64_tr_b16 v[64:65], v28 offset:0
    ds_read_b64_tr_b16 v[66:67], v28 offset:512
    ds_read_b64_tr_b16 v[68:69], v29 offset:0
    ds_read_b64_tr_b16 v[70:71], v29 offset:512
    ds_read_b64_tr_b16 v[72:73], v28 offset:2048
    ds_read_b64_tr_b16 v[74:75], v28 offset:2560
    ds_read_b64_tr_b16 v[76:77], v29 offset:2048
    ds_read_b64_tr_b16 v[78:79], v29 offset:2560
    ds_read_b64_tr_b16 v[80:81], v28 offset:4096
    ds_read_b64_tr_b16 v[82:83], v28 offset:4608
    ds_read_b64_tr_b16 v[84:85], v29 offset:4096
    ds_read_b64_tr_b16 v[86:87], v29 offset:4608
P2_L:
    s_add_u32 s37, s43, s58
    s_add_u32 s37, s37, 2
    s_and_b32 s37, s37, 7
    s_lshl_b32 s37, s37, 18
    s_add_u32 s37, s37, s56
    s_cmp_ge_u32 s58, 6
    s_cselect_b32 s37, 0x40000000, s37
    s_add_u32 s38, s43, s58
    s_add_u32 s38, s38, 3
    s_and_b32 s38, s38, 7
    s_lshl_b32 s38, s38, 18
    s_add_u32 s38, s38, s56
    s_cmp_ge_u32 s58, 6
    s_cselect_b32 s38, 0x40000000, s38
    s_waitcnt vmcnt(11) lgkmcnt(8)
    v_mfma_f32_32x32x16_bf16 v[168:183], v[64:67], v[136:139], v[168:183]
    ds_read_b64_tr_b16 v[88:89], v28 offset:6144
    ds_read_b64_tr_b16 v[90:91], v28 offset:6656
    buffer_load_dwordx4 v[48:51], v3, s[20:23], s36 offen offset:0 sc1
    v_mfma_f32_32x32x16_bf16 v[184:199], v[68:71], v[136:139], v[184:199]
    ds_read_b64_tr_b16 v[92:93], v29 offset:6144
    ds_read_b64_tr_b16 v[94:95], v29 offset:6656
    s_waitcnt vmcnt(11) lgkmcnt(8)
    v_mfma_f32_32x32x16_bf16 v[168:183], v[72:75], v[140:143], v[168:183]
    ds_read_b64_tr_b16 v[64:65], v28 offset:8192
    ds_read_b64_tr_b16 v[66:67], v28 offset:8704
    buffer_load_dwordx4 v[52:55], v3, s[20:23], s36 offen offset:1024 sc1
    v_mfma_f32_32x32x16_bf16 v[184:199], v[76:79], v[140:143], v[184:199]
    ds_read_b64_tr_b16 v[68:69], v29 offset:8192
    ds_read_b64_tr_b16 v[70:71], v29 offset:8704
    s_waitcnt vmcnt(11) lgkmcnt(8)
    v_mfma_f32_32x32x16_bf16 v[168:183], v[80:83], v[144:147], v[168:183]
    ds_read_b64_tr_b16 v[72:73], v28 offset:10240
    ds_read_b64_tr_b16 v[74:75], v28 offset:10752
    buffer_load_dwordx4 v[56:59], v3, s[20:23], s36 offen offset:2048 sc1
    v_mfma_f32_32x32x16_bf16 v[184:199], v[84:87], v[144:147], v[184:199]
    ds_read_b64_tr_b16 v[76:77], v29 offset:10240
    ds_read_b64_tr_b16 v[78:79], v29 offset:10752
    s_waitcnt vmcnt(11) lgkmcnt(8)
    v_mfma_f32_32x32x16_bf16 v[168:183], v[88:91], v[148:151], v[168:183]
    ds_read_b64_tr_b16 v[80:81], v28 offset:12288
    ds_read_b64_tr_b16 v[82:83], v28 offset:12800
    buffer_load_dwordx4 v[60:63], v3, s[20:23], s36 offen offset:3072 sc1
    v_mfma_f32_32x32x16_bf16 v[184:199], v[92:95], v[148:151], v[184:199]
    ds_read_b64_tr_b16 v[84:85], v29 offset:12288
    ds_read_b64_tr_b16 v[86:87], v29 offset:12800
    s_waitcnt vmcnt(11) lgkmcnt(8)
    v_mfma_f32_32x32x16_bf16 v[168:183], v[64:67], v[152:155], v[168:183]
    ds_read_b64_tr_b16 v[88:89], v28 offset:14336
    ds_read_b64_tr_b16 v[90:91], v28 offset:14848
    buffer_load_dwordx4 v[136:139], v6, s[20:23], s37 offen offset:0 sc1
    v_mfma_f32_32x32x16_bf16 v[184:199], v[68:71], v[152:155], v[184:199]
    ds_read_b64_tr_b16 v[92:93], v29 offset:14336
    ds_read_b64_tr_b16 v[94:95], v29 offset:14848
    s_waitcnt vmcnt(11) lgkmcnt(8)
    v_mfma_f32_32x32x16_bf16 v[168:183], v[72:75], v[156:159], v[168:183]
    ds_read_b64_tr_b16 v[64:65], v28 offset:16384
    ds_read_b64_tr_b16 v[66:67], v28 offset:16896
    buffer_load_dwordx4 v[140:143], v6, s[20:23], s37 offen offset:1024 sc1
    v_mfma_f32_32x32x16_bf16 v[184:199], v[76:79], v[156:159], v[184:199]
    ds_read_b64_tr_b16 v[68:69], v29 offset:16384
    ds_read_b64_tr_b16 v[70:71], v29 offset:16896
    s_waitcnt vmcnt(11) lgkmcnt(8)
    v_mfma_f32_32x32x16_bf16 v[168:183], v[80:83], v[160:163], v[168:183]
    ds_read_b64_tr_b16 v[72:73], v28 offset:18432
    ds_read_b64_tr_b16 v[74:75], v28 offset:18944
    buffer_load_dwordx4 v[144:147], v6, s[20:23], s37 offen offset:2048 sc1
    v_mfma_f32_32x32x16_bf16 v[184:199], v[84:87], v[160:163], v[184:199]
    ds_read_b64_tr_b16 v[76:77], v29 offset:18432
    ds_read_b64_tr_b16 v[78:79], v29 offset:18944
    s_waitcnt vmcnt(11) lgkmcnt(8)
    v_mfma_f32_32x32x16_bf16 v[168:183], v[88:91], v[164:167], v[168:183]
    ds_read_b64_tr_b16 v[80:81], v28 offset:20480
    ds_read_b64_tr_b16 v[82:83], v28 offset:20992
    buffer_load_dwordx4 v[148:151], v6, s[20:23], s37 offen offset:3072 sc1
    v_mfma_f32_32x32x16_bf16 v[184:199], v[92:95], v[164:167], v[184:199]
    ds_read_b64_tr_b16 v[84:85], v29 offset:20480
    ds_read_b64_tr_b16 v[86:87], v29 offset:20992
    s_waitcnt vmcnt(11) lgkmcnt(8)
    v_mfma_f32_32x32x16_bf16 v[168:183], v[64:67], v[32:35], v[168:183]
    ds_read_b64_tr_b16 v[88:89], v28 offset:22528
    ds_read_b64_tr_b16 v[90:91], v28 offset:23040
    buffer_load_dwordx4 v[152:155], v3, s[20:23], s37 offen offset:0 sc1
    v_mfma_f32_32x32x16_bf16 v[184:199], v[68:71], v[32:35], v[184:199]
    ds_read_b64_tr_b16 v[92:93], v29 offset:22528
    ds_read_b64_tr_b16 v[94:95], v29 offset:23040
    s_waitcnt vmcnt(11) lgkmcnt(8)
    v_mfma_f32_32x32x16_bf16 v[168:183], v[72:75], v[36:39], v[168:183]
    ds_read_b64_tr_b16 v[64:65], v28 offset:24576
    ds_read_b64_tr_b16 v[66:67], v28 offset:25088
    buffer_load_dwordx4 v[156:159], v3, s[20:23], s37 offen offset:1024 sc1
    v_mfma_f32_32x32x16_bf16 v[184:199], v[76:79], v[36:39], v[184:199]
    ds_read_b64_tr_b16 v[68:69], v29 offset:24576
    ds_read_b64_tr_b16 v[70:71], v29 offset:25088
    s_waitcnt vmcnt(11) lgkmcnt(8)
    v_mfma_f32_32x32x16_bf16 v[168:183], v[80:83], v[40:43], v[168:183]
    ds_read_b64_tr_b16 v[72:73], v28 offset:26624
    ds_read_b64_tr_b16 v[74:75], v28 offset:27136
    buffer_load_dwordx4 v[160:163], v3, s[20:23], s37 offen offset:2048 sc1
    v_mfma_f32_32x32x16_bf16 v[184:199], v[84:87], v[40:43], v[184:199]
    ds_read_b64_tr_b16 v[76:77], v29 offset:26624
    ds_read_b64_tr_b16 v[78:79], v29 offset:27136
    s_waitcnt vmcnt(11) lgkmcnt(8)
    v_mfma_f32_32x32x16_bf16 v[168:183], v[88:91], v[44:47], v[168:183]
    ds_read_b64_tr_b16 v[80:81], v28 offset:28672
    ds_read_b64_tr_b16 v[82:83], v28 offset:29184
    buffer_load_dwordx4 v[164:167], v3, s[20:23], s37 offen offset:3072 sc1
    v_mfma_f32_32x32x16_bf16 v[184:199], v[92:95], v[44:47], v[184:199]
    ds_read_b64_tr_b16 v[84:85], v29 offset:28672
    ds_read_b64_tr_b16 v[86:87], v29 offset:29184
    s_waitcnt vmcnt(11) lgkmcnt(8)
    v_mfma_f32_32x32x16_bf16 v[168:183], v[64:67], v[48:51], v[168:183]
    ds_read_b64_tr_b16 v[88:89], v28 offset:30720
    ds_read_b64_tr_b16 v[90:91], v28 offset:31232
    buffer_load_dwordx4 v[32:35], v6, s[20:23], s38 offen offset:0 sc1
    v_mfma_f32_32x32x16_bf16 v[184:199], v[68:71], v[48:51], v[184:199]
    ds_read_b64_tr_b16 v[92:93], v29 offset:30720
    ds_read_b64_tr_b16 v[94:95], v29 offset:31232
    s_waitcnt vmcnt(11) lgkmcnt(8)
    v_mfma_f32_32x32x16_bf16 v[168:183], v[72:75], v[52:55], v[168:183]
    ds_read_b64_tr_b16 v[64:65], v28 offset:32768
    ds_read_b64_tr_b16 v[66:67], v28 offset:33280
    buffer_load_dwordx4 v[36:39], v6, s[20:23], s38 offen offset:1024 sc1
    v_mfma_f32_32x32x16_bf16 v[184:199], v[76:79], v[52:55], v[184:199]
    ds_read_b64_tr_b16 v[68:69], v29 offset:32768
    ds_read_b64_tr_b16 v[70:71], v29 offset:33280
    s_waitcnt vmcnt(11) lgkmcnt(8)
    v_mfma_f32_32x32x16_bf16 v[168:183], v[80:83], v[56:59], v[168:183]
    ds_read_b64_tr_b16 v[72:73], v28 offset:34816
    ds_read_b64_tr_b16 v[74:75], v28 offset:35328
    buffer_load_dwordx4 v[40:43], v6, s[20:23], s38 offen offset:2048 sc1
    v_mfma_f32_32x32x16_bf16 v[184:199], v[84:87], v[56:59], v[184:199]
    ds_read_b64_tr_b16 v[76:77], v29 offset:34816
    ds_read_b64_tr_b16 v[78:79], v29 offset:35328
    s_waitcnt vmcnt(11) lgkmcnt(8)
    v_mfma_f32_32x32x16_bf16 v[168:183], v[88:91], v[60:63], v[168:183]
    ds_read_b64_tr_b16 v[80:81], v28 offset:36864
    ds_read_b64_tr_b16 v[82:83], v28 offset:37376
    buffer_load_dwordx4 v[44:47], v6, s[20:23], s38 offen offset:3072 sc1
    v_mfma_f32_32x32x16_bf16 v[184:199], v[92:95], v[60:63], v[184:199]
    ds_read_b64_tr_b16 v[84:85], v29 offset:36864
    ds_read_b64_tr_b16 v[86:87], v29 offset:37376
    v_add_u32 v28, 0x8000, v28
    v_add_u32 v29, 0x8000, v29
    s_mov_b32 s36, s38
    s_add_u32 s58, s58, 2
    s_cmp_lt_u32 s58, 8
    s_cbranch_scc1 P2_L
    s_waitcnt lgkmcnt(0)
    s_nop 7
    s_nop 3
    s_waitcnt vmcnt(0)
    v_max3_f32 v216, |v168|, |v169|, |v170|
    v_max3_f32 v217, |v171|, |v172|, |v173|
    v_max3_f32 v216, v216, |v174|, |v175|
    v_max3_f32 v217, v217, |v176|, |v177|
    v_max3_f32 v216, v216, |v178|, |v179|
    v_max3_f32 v217, v217, |v180|, |v181|
    v_max3_f32 v216, v216, |v182|, |v183|
    v_max3_f32 v217, v217, |v184|, |v185|
    v_max3_f32 v216, v216, |v186|, |v187|
    v_max3_f32 v217, v217, |v188|, |v189|
    v_max3_f32 v216, v216, |v190|, |v191|
    v_max3_f32 v217, v217, |v192|, |v193|
    v_max3_f32 v216, v216, |v194|, |v195|
    v_max3_f32 v217, v217, |v196|, |v197|
    v_max3_f32 v216, v216, |v198|, |v199|
    v_max_f32 v216, v216, v217
    v_bfe_u32 v2, v1, 3, 2
    v_and_b32 v3, 7, v1
    v_max_u32_dpp v216, v216, v216 quad_perm:[1,0,3,2] row_mask:0xf bank_mask:0xf
    v_lshrrev_b32 v4, 5, v1
    v_lshl_add_u32 v3, v4, 3, v3
    v_max_u32_dpp v216, v216, v216 quad_perm:[2,3,0,1] row_mask:0xf bank_mask:0xf
    v_lshlrev_b32 v164, 14, v2
    v_lshl_add_u32 v164, v3, 4, v164
    v_max_u32_dpp v216, v216, v216 row_half_mirror row_mask:0xf bank_mask:0xf
    v_lshlrev_b32 v165, 11, v2
    v_lshl_add_u32 v165, v4, 6, v165
    v_max_u32_dpp v216, v216, v216 row_mirror row_mask:0xf bank_mask:0xf
    v_cmp_eq_u32 s[38:39], s44, v2
    v_lshlrev_b32 v166, 5, v3
    v_readlane_b32 s32, v216, 0
    v_readlane_b32 s33, v216, 16
    v_readlane_b32 s34, v216, 32
    v_readlane_b32 s35, v216, 48
    s_lshl_b32 s46, s42, 11
    s_add_u32 s46, s46, 131072
    v_add_u32 v166, s46, v166
    s_not_b64 s[36:37], s[38:39]
    s_max_u32 s32, s32, s33
    s_max_u32 s34, s34, s35
    s_max_u32 s32, s32, s34
    s_lshr_b32 s32, s32, 23
    s_max_u32 s32, s32, 15
    s_sub_u32 s34, s32, 14
    s_lshl_b32 s34, s34, 23
    s_sub_u32 s32, 0x10c, s32
    s_lshl_b32 s32, s32, 23
    s_mov_b32 s33, s32
    s_andn2_b32 s49, s2, 3
    s_lshl_b32 s49, s49, 2
    s_add_u32 s49, s49, s44
    s_lshl_b32 s49, s49, 2
    s_add_u32 s49, s49, s42
    s_lshl_b32 s51, s49, 7
    s_add_u32 s51, s51, 18874368
    s_lshl_b32 s49, s49, 10
    s_add_u32 s49, s49, 8388608
    v_pk_mul_f32 v[72:73], v[168:169], s[32:33]
    v_pk_mul_f32 v[74:75], v[170:171], s[32:33]
    v_pk_mul_f32 v[76:77], v[172:173], s[32:33]
    v_pk_mul_f32 v[78:79], v[174:175], s[32:33]
    v_cvt_pk_f16_f32 v136, v72, v73
    v_cvt_pk_f16_f32 v137, v74, v75
    v_cvt_pk_f16_f32 v138, v76, v77
    v_cvt_pk_f16_f32 v139, v78, v79
    s_mov_b64 exec, s[36:37]
    buffer_store_dwordx4 v[136:139], v164, s[20:23], s49 offen offset:0 sc1
    s_mov_b64 exec, -1
    v_pk_mul_f32 v[80:81], v[176:177], s[32:33]
    v_pk_mul_f32 v[82:83], v[178:179], s[32:33]
    v_pk_mul_f32 v[84:85], v[180:181], s[32:33]
    v_pk_mul_f32 v[86:87], v[182:183], s[32:33]
    v_cvt_pk_f16_f32 v140, v80, v81
    v_cvt_pk_f16_f32 v141, v82, v83
    v_cvt_pk_f16_f32 v142, v84, v85
    v_cvt_pk_f16_f32 v143, v86, v87
    s_mov_b64 exec, s[36:37]
    buffer_store_dwordx4 v[140:143], v164, s[20:23], s49 offen offset:256 sc1
    s_mov_b64 exec, -1
    v_pk_mul_f32 v[72:73], v[184:185], s[32:33]
    v_pk_mul_f32 v[74:75], v[186:187], s[32:33]
    v_pk_mul_f32 v[76:77], v[188:189], s[32:33]
    v_pk_mul_f32 v[78:79], v[190:191], s[32:33]
    v_cvt_pk_f16_f32 v144, v72, v73
    v_cvt_pk_f16_f32 v145, v74, v75
    v_cvt_pk_f16_f32 v146, v76, v77
    v_cvt_pk_f16_f32 v147, v78, v79
    s_mov_b64 exec, s[36:37]
    buffer_store_dwordx4 v[144:147], v164, s[20:23], s49 offen offset:512 sc1
    s_mov_b64 exec, -1
    v_pk_mul_f32 v[80:81], v[192:193], s[32:33]
    v_pk_mul_f32 v[82:83], v[194:195], s[32:33]
    v_pk_mul_f32 v[84:85], v[196:197], s[32:33]
    v_pk_mul_f32 v[86:87], v[198:199], s[32:33]
    v_cvt_pk_f16_f32 v148, v80, v81
    v_cvt_pk_f16_f32 v149, v82, v83
    v_cvt_pk_f16_f32 v150, v84, v85
    v_cvt_pk_f16_f32 v151, v86, v87
    s_mov_b64 exec, s[36:37]
    buffer_store_dwordx4 v[148:151], v164, s[20:23], s49 offen offset:768 sc1
    s_mov_b64 exec, -1
    v_bitop3_b32 v100, v136, v137, v138 bitop3:0x96
    v_xor_b32 v100, v100, v139
    v_bitop3_b32 v101, v140, v141, v142 bitop3:0x96
    v_xor_b32 v101, v101, v143
    v_bitop3_b32 v102, v144, v145, v146 bitop3:0x96
    v_xor_b32 v102, v102, v147
    v_bitop3_b32 v103, v148, v149, v150 bitop3:0x96
    v_xor_b32 v103, v103, v151
    v_and_b32 v5, 3, v1
    v_lshl_add_u32 v165, v5, 4, v165
    v_xor_b32_dpp v100, v100, v100 quad_perm:[1,0,3,2] row_mask:0xf bank_mask:0xf
    v_xor_b32_dpp v101, v101, v101 quad_perm:[1,0,3,2] row_mask:0xf bank_mask:0xf
    v_xor_b32_dpp v102, v102, v102 quad_perm:[1,0,3,2] row_mask:0xf bank_mask:0xf
    v_xor_b32_dpp v103, v103, v103 quad_perm:[1,0,3,2] row_mask:0xf bank_mask:0xf
    v_xor_b32_dpp v100, v100, v100 quad_perm:[2,3,0,1] row_mask:0xf bank_mask:0xf
    v_xor_b32_dpp v101, v101, v101 quad_perm:[2,3,0,1] row_mask:0xf bank_mask:0xf
    v_xor_b32_dpp v102, v102, v102 quad_perm:[2,3,0,1] row_mask:0xf bank_mask:0xf
    v_xor_b32_dpp v103, v103, v103 quad_perm:[2,3,0,1] row_mask:0xf bank_mask:0xf
    v_xor_b32_dpp v100, v100, v100 row_half_mirror row_mask:0xf bank_mask:0xf
    v_xor_b32_dpp v101, v101, v101 row_half_mirror row_mask:0xf bank_mask:0xf
    v_xor_b32_dpp v102, v102, v102 row_half_mirror row_mask:0xf bank_mask:0xf
    v_xor_b32_dpp v103, v103, v103 row_half_mirror row_mask:0xf bank_mask:0xf
    s_mov_b32 s56, 0xaaaaaaaa
    s_mov_b32 s57, 0xaaaaaaaa
    s_mov_b32 s60, 0xcccccccc
    s_mov_b32 s61, 0xcccccccc
    v_cndmask_b32 v100, v100, v101, s[56:57]
    v_cndmask_b32 v102, v102, v103, s[56:57]
    v_mov_b32 v97, s52
    v_cndmask_b32 v96, v100, v102, s[60:61]
    v_mov_b32 v98, s34
    v_mov_b32 v99, 0
    v_bitop3_b32 v96, v96, v98, s53 bitop3:0x96
    s_mov_b32 exec_lo, 0x0f0f0f0f
    s_mov_b32 exec_hi, 0x0f0f0f0f
    buffer_store_dwordx4 v[96:99], v165, s[20:23], s51 offen sc1
    s_mov_b64 exec, s[38:39]
    ds_write_b128 v166, v[168:171] offset:0
    ds_write_b128 v166, v[172:175] offset:16
    ds_write_b128 v166, v[176:179] offset:512
    ds_write_b128 v166, v[180:183] offset:528
    ds_write_b128 v166, v[184:187] offset:1024
    ds_write_b128 v166, v[188:191] offset:1040
    ds_write_b128 v166, v[192:195] offset:1536
    ds_write_b128 v166, v[196:199] offset:1552
    s_mov_b64 exec, -1
    v_lshlrev_b32 v166, 5, v1
    v_add_u32 v166, s46, v166
    s_lshl_b32 s49, s2, 4
    s_add_u32 s49, s49, s42
    s_lshl_b32 s51, s49, 7
    s_add_u32 s51, s51, 18874368
    s_lshl_b32 s49, s49, 10
    s_add_u32 s49, s49, 8388608
    s_add_u32 s46, s44, 1
    s_and_b32 s46, s46, 3
    s_lshl_b32 s36, s46, 9
    s_add_u32 s36, s36, s51
    s_lshl_b32 s32, s46, 12
    s_add_u32 s32, s32, s49
    s_add_u32 s46, s44, 2
    s_and_b32 s46, s46, 3
    s_lshl_b32 s37, s46, 9
    s_add_u32 s37, s37, s51
    s_lshl_b32 s33, s46, 12
    s_add_u32 s33, s33, s49
    s_add_u32 s46, s44, 3
    s_and_b32 s46, s46, 3
    s_lshl_b32 s38, s46, 9
    s_add_u32 s38, s38, s51
    s_lshl_b32 s34, s46, 12
    s_add_u32 s34, s34, s49
    s_waitcnt lgkmcnt(0)
    ds_read_b128 v[112:115], v166
    ds_read_b128 v[116:119], v166 offset:16
    v_lshrrev_b32 v167, 3, v1
    v_lshlrev_b32 v167, 4, v167
    v_and_b32 v7, 7, v1
    v_lshl_add_u32 v7, v7, 10, v167
    v_bfe_u32 v167, v1, 3, 1
    v_lshlrev_b32 v167, 6, v167
    v_lshrrev_b32 v5, 4, v1
    v_lshl_add_u32 v167, v5, 4, v167
    v_add_u32 v5, s44, v1
    v_add_u32 v5, 1, v5
    v_and_b32 v5, 3, v5
    v_lshlrev_b32 v5, 9, v5
    s_mov_b32 s50, 0
    s_mov_b64 exec, 7
F_P2:
    buffer_load_dword v224, v5, s[20:23], s51 offen offset:116 sc0 sc1
    s_add_u32 s50, s50, 1
    s_waitcnt vmcnt(0)
    v_cmp_ne_u32 vcc, s52, v224
    s_cmp_gt_u32 s50, 200000
    s_cbranch_scc1 F_P2X
    s_nop 2
    s_cbranch_vccnz F_P2
F_P2X:
    s_mov_b64 exec, -1
    buffer_load_dwordx4 v[72:75], v6, s[20:23], s32 offen sc1
    buffer_load_dwordx3 v[152:154], v167, s[20:23], s36 offen sc1
    buffer_load_dwordx4 v[76:79], v6, s[20:23], s33 offen sc1
    buffer_load_dwordx3 v[156:158], v167, s[20:23], s37 offen sc1
    buffer_load_dwordx4 v[80:83], v6, s[20:23], s34 offen sc1
    buffer_load_dwordx3 v[160:162], v167, s[20:23], s38 offen sc1
    s_branch F_RV
F_RX:
    buffer_load_dwordx4 v[72:75], v6, s[20:23], s32 offen sc0 sc1
    buffer_load_dwordx3 v[152:154], v167, s[20:23], s36 offen sc0 sc1
    buffer_load_dwordx4 v[76:79], v6, s[20:23], s33 offen sc0 sc1
    buffer_load_dwordx3 v[156:158], v167, s[20:23], s37 offen sc0 sc1
    buffer_load_dwordx4 v[80:83], v6, s[20:23], s34 offen sc0 sc1
    buffer_load_dwordx3 v[160:162], v167, s[20:23], s38 offen sc0 sc1
F_RV:
    s_add_u32 s50, s50, 1
    s_waitcnt vmcnt(4)
    v_bitop3_b32 v124, v72, v73, v74 bitop3:0x96
    v_xor_b32 v124, v124, v75
    s_waitcnt vmcnt(2)
    v_bitop3_b32 v125, v76, v77, v78 bitop3:0x96
    v_xor_b32 v125, v125, v79
    s_waitcnt vmcnt(0)
    v_bitop3_b32 v126, v80, v81, v82 bitop3:0x96
    v_xor_b32 v126, v126, v83
    s_nop 1
    v_xor_b32_dpp v124, v124, v124 quad_perm:[1,0,3,2] row_mask:0xf bank_mask:0xf
    v_xor_b32_dpp v125, v125, v125 quad_perm:[1,0,3,2] row_mask:0xf bank_mask:0xf
    v_xor_b32_dpp v126, v126, v126 quad_perm:[1,0,3,2] row_mask:0xf bank_mask:0xf
    v_xor_b32_dpp v124, v124, v124 quad_perm:[2,3,0,1] row_mask:0xf bank_mask:0xf
    v_xor_b32_dpp v125, v125, v125 quad_perm:[2,3,0,1] row_mask:0xf bank_mask:0xf
    v_xor_b32_dpp v126, v126, v126 quad_perm:[2,3,0,1] row_mask:0xf bank_mask:0xf
    v_xor_b32_dpp v124, v124, v124 row_half_mirror row_mask:0xf bank_mask:0xf
    v_xor_b32_dpp v125, v125, v125 row_half_mirror row_mask:0xf bank_mask:0xf
    v_xor_b32_dpp v126, v126, v126 row_half_mirror row_mask:0xf bank_mask:0xf
    v_bitop3_b32 v124, v124, v152, s53 bitop3:0x96
    v_xor_b32 v124, v124, v154
    v_xor_b32 v153, s52, v153
    v_bitop3_b32 v125, v125, v156, s53 bitop3:0x96
    v_xor_b32 v125, v125, v158
    v_xor_b32 v157, s52, v157
    v_bitop3_b32 v126, v126, v160, s53 bitop3:0x96
    v_xor_b32 v126, v126, v162
    v_xor_b32 v161, s52, v161
    v_or3_b32 v5, v124, v125, v126
    v_or3_b32 v5, v5, v153, v157
    v_or_b32 v5, v5, v161
    v_cmp_ne_u32 vcc, 0, v5
    s_cmp_gt_u32 s50, 200000
    s_cbranch_scc1 F_RXX
    s_nop 2
    s_cbranch_vccnz F_RX
F_RXX:
    s_lshl_b32 s46, s41, 2
    s_add_u32 s46, s46, s42
    s_lshl_b32 s46, s46, 2
    s_add_u32 s46, s46, s44
    s_lshl_b32 s46, s46, 13
    s_lshl_b32 s47, s43, 7
    s_add_u32 s46, s46, s47
    s_waitcnt lgkmcnt(0)
    v_fma_mix_f32 v112, v72, v154, v112 op_sel_hi:[1,0,0]
    v_fma_mix_f32 v113, v72, v154, v113 op_sel:[1,0,0] op_sel_hi:[1,0,0]
    v_fma_mix_f32 v114, v73, v154, v114 op_sel_hi:[1,0,0]
    v_fma_mix_f32 v115, v73, v154, v115 op_sel:[1,0,0] op_sel_hi:[1,0,0]
    v_fma_mix_f32 v116, v74, v154, v116 op_sel_hi:[1,0,0]
    v_fma_mix_f32 v117, v74, v154, v117 op_sel:[1,0,0] op_sel_hi:[1,0,0]
    v_fma_mix_f32 v118, v75, v154, v118 op_sel_hi:[1,0,0]
    v_fma_mix_f32 v119, v75, v154, v119 op_sel:[1,0,0] op_sel_hi:[1,0,0]
    v_fma_mix_f32 v112, v76, v158, v112 op_sel_hi:[1,0,0]
    v_fma_mix_f32 v113, v76, v158, v113 op_sel:[1,0,0] op_sel_hi:[1,0,0]
    v_fma_mix_f32 v114, v77, v158, v114 op_sel_hi:[1,0,0]
    v_fma_mix_f32 v115, v77, v158, v115 op_sel:[1,0,0] op_sel_hi:[1,0,0]
    v_fma_mix_f32 v116, v78, v158, v116 op_sel_hi:[1,0,0]
    v_fma_mix_f32 v117, v78, v158, v117 op_sel:[1,0,0] op_sel_hi:[1,0,0]
    v_fma_mix_f32 v118, v79, v158, v118 op_sel_hi:[1,0,0]
    v_fma_mix_f32 v119, v79, v158, v119 op_sel:[1,0,0] op_sel_hi:[1,0,0]
    v_fma_mix_f32 v112, v80, v162, v112 op_sel_hi:[1,0,0]
    v_fma_mix_f32 v113, v80, v162, v113 op_sel:[1,0,0] op_sel_hi:[1,0,0]
    v_fma_mix_f32 v114, v81, v162, v114 op_sel_hi:[1,0,0]
    v_fma_mix_f32 v115, v81, v162, v115 op_sel:[1,0,0] op_sel_hi:[1,0,0]
    v_fma_mix_f32 v116, v82, v162, v116 op_sel_hi:[1,0,0]
    v_fma_mix_f32 v117, v82, v162, v117 op_sel:[1,0,0] op_sel_hi:[1,0,0]
    v_fma_mix_f32 v118, v83, v162, v118 op_sel_hi:[1,0,0]
    v_fma_mix_f32 v119, v83, v162, v119 op_sel:[1,0,0] op_sel_hi:[1,0,0]
    v_cvt_pk_bf16_f32 v120, v112, v113
    v_cvt_pk_bf16_f32 v121, v114, v115
    v_cvt_pk_bf16_f32 v122, v116, v117
    v_cvt_pk_bf16_f32 v123, v118, v119
    buffer_store_dwordx4 v[120:123], v7, s[28:31], s46 offen
F_DONE:
    s_endpgm
.section .rodata,"a"
.p2align 6
.amdhsa_kernel standalone__gqa_block_cached__near_ridge_kernel
  .amdhsa_next_free_vgpr 232
  .amdhsa_next_free_sgpr 100
  .amdhsa_accum_offset 232
  .amdhsa_group_segment_fixed_size 0
  .amdhsa_kernarg_size 64
  .amdhsa_user_sgpr_count 2
  .amdhsa_user_sgpr_kernarg_segment_ptr 1
  .amdhsa_system_sgpr_workgroup_id_x 1
.end_amdhsa_kernel
```
